```python
import torch

def _softmax(x, axis=-1):
    return torch.softmax(x, dim=axis)
def _gelu(x):
    return torch.nn.functional.gelu(x, approximate="tanh")
def _silu(x):
    return torch.nn.functional.silu(x)
def _sigmoid(x):
    return torch.sigmoid(x)
def _layernorm(x, axis=-1, eps=1e-5):
    m = x.mean(dim=axis, keepdim=True)
    v = x.var(dim=axis, keepdim=True, unbiased=False)
    return (x - m) / torch.sqrt(v + eps)
def _scatter_add(tgt, idx, src, axis=0):
    return tgt.clone().index_add_(axis, idx, src)
def _segment_sum(src, seg, n):
    out = torch.zeros((n,) + src.shape[1:], dtype=src.dtype)
    return out.index_add_(0, seg, src)
def _pad(x, pw):
    flat = tuple(v for pair in reversed(pw) for v in pair)
    return torch.nn.functional.pad(x, flat)

kernel_name = 'standalone__groupnorm__sampling'

def setup_inputs():

    _w = (lambda a: (lambda t: t.to(torch.bfloat16) if t.is_floating_point() else t)(torch.as_tensor(a)))
    B = 32
    G = 32
    cpg = max(1, 576 // G)
    C = G * cpg
    H, W = 32, 16
    return {
        "x": _w(abs((lambda *s: torch.randn(*s, dtype=torch.bfloat16) * 0.05)(B, C, H, W))),
        "g": _w((lambda *s: torch.randn(*s, dtype=torch.bfloat16) * 0.05)(C) + 1.0),
        "b": _w((lambda *s: torch.randn(*s, dtype=torch.bfloat16) * 0.4)(C)),
    }

def reference(x, g, b):
    G = 32
    B, C, H, W = x.shape[0], x.shape[1], x.shape[2], x.shape[3]
    xr = x.reshape(B, G, C // G, H, W)
    mu = xr.mean(axis=(2, 3, 4), keepdims=True)
    var = ((xr - mu) ** 2).mean(axis=(2, 3, 4), keepdims=True)
    xn = (xr - mu) / torch.sqrt(var + 1e-5)
    xn = xn.reshape(B, C, H, W)
    return xn * g[None, :, None, None] + b[None, :, None, None]
```

```asm
; @launch grid=(1024,1,1) block=(64,1,1) lds=0
.amdgcn_target "amdgcn-amd-amdhsa--gfx950"
.text
.globl standalone__groupnorm__sampling_kernel
.p2align 8
.type standalone__groupnorm__sampling_kernel,@function
standalone__groupnorm__sampling_kernel:
    s_load_dwordx2 s[4:5], s[0:1], 0
    s_cmpk_ge_u32 s2, 1024
    s_cbranch_scc1 L_end
    s_cmpk_ge_u32 s2, 256
    s_cbranch_scc1 L_nopf
    s_getpc_b64 s[16:17]
    v_lshlrev_b32 v2, 7, v0
    v_min_u32 v2, (L_end-standalone__groupnorm__sampling_kernel-128)&~3, v2
    global_load_dword v3, v2, s[16:17]
L_nopf:
    s_mul_i32 s3, s2, 18432
    v_lshlrev_b32 v0, 4, v0
    s_mov_b32 s6, 18874368
    s_mov_b32 s7, 0x20000
    s_add_u32 s22, s3, 4096
    s_add_u32 s23, s3, 8192
    s_add_u32 s24, s3, 12288
    s_add_u32 s25, s3, 16384
    s_waitcnt lgkmcnt(0)
    buffer_load_dwordx4 v[16:19], v0, s[4:7], s3 offen nt
    buffer_load_dwordx4 v[24:27], v0, s[4:7], s3 offen offset:1024 nt
    buffer_load_dwordx4 v[32:35], v0, s[4:7], s3 offen offset:2048 nt
    buffer_load_dwordx4 v[40:43], v0, s[4:7], s3 offen offset:3072 nt
    buffer_load_dwordx4 v[48:51], v0, s[4:7], s22 offen nt
    buffer_load_dwordx4 v[56:59], v0, s[4:7], s22 offen offset:1024 nt
    buffer_load_dwordx4 v[64:67], v0, s[4:7], s22 offen offset:2048 nt
    buffer_load_dwordx4 v[72:75], v0, s[4:7], s22 offen offset:3072 nt
    buffer_load_dwordx4 v[80:83], v0, s[4:7], s23 offen nt
    buffer_load_dwordx4 v[88:91], v0, s[4:7], s23 offen offset:1024 nt
    buffer_load_dwordx4 v[96:99], v0, s[4:7], s23 offen offset:2048 nt
    buffer_load_dwordx4 v[104:107], v0, s[4:7], s23 offen offset:3072 nt
    buffer_load_dwordx4 v[112:115], v0, s[4:7], s24 offen nt
    buffer_load_dwordx4 v[120:123], v0, s[4:7], s24 offen offset:1024 nt
    buffer_load_dwordx4 v[128:131], v0, s[4:7], s24 offen offset:2048 nt
    buffer_load_dwordx4 v[136:139], v0, s[4:7], s24 offen offset:3072 nt
    buffer_load_dwordx4 v[144:147], v0, s[4:7], s25 offen nt
    buffer_load_dwordx4 v[152:155], v0, s[4:7], s25 offen offset:1024 nt
    s_load_dwordx2 s[8:9], s[0:1], 24
    s_load_dwordx4 s[12:15], s[0:1], 8
    s_and_b32 s18, s2, 31
    s_mul_i32 s18, s18, 36
    s_waitcnt lgkmcnt(0)
    s_load_dwordx8 s[28:35], s[12:13], s18
    s_load_dword s36, s[12:13], s18 offset:32
    s_load_dwordx8 s[40:47], s[14:15], s18
    s_load_dword s48, s[14:15], s18 offset:32
    s_movk_i32 s20, 0x3f80
    s_mov_b32 s21, 0x3f800000
    s_mov_b32 s10, 18874368
    s_mov_b32 s11, 0x20000
    v_mov_b32 v8, 0
    v_mov_b32 v9, 0x3727c5ac
    v_mov_b32 v6, 0x38e38e39
    s_waitcnt vmcnt(17)
    v_readfirstlane_b32 s19, v16
    s_nop 0
    s_lshl_b32 s19, s19, 16
    v_mov_b32 v7, s19
    v_dot2_f32_bf16 v12, v16, s20, v7 neg_lo:[0,0,1]
    v_dot2_f32_bf16 v13, v16, s21, v7 neg_lo:[0,0,1]
    v_dot2_f32_bf16 v14, v17, s20, v7 neg_lo:[0,0,1]
    v_dot2_f32_bf16 v15, v17, s21, v7 neg_lo:[0,0,1]
    v_dot2_f32_bf16 v16, v18, s20, v7 neg_lo:[0,0,1]
    v_dot2_f32_bf16 v17, v18, s21, v7 neg_lo:[0,0,1]
    v_dot2_f32_bf16 v18, v19, s20, v7 neg_lo:[0,0,1]
    v_dot2_f32_bf16 v19, v19, s21, v7 neg_lo:[0,0,1]
    v_pk_mul_f32 v[4:5], v[12:13], v[12:13]
    v_pk_fma_f32 v[4:5], v[14:15], v[14:15], v[4:5]
    v_pk_add_f32 v[2:3], v[12:13], v[14:15]
    v_pk_fma_f32 v[4:5], v[16:17], v[16:17], v[4:5]
    v_pk_add_f32 v[2:3], v[2:3], v[16:17]
    v_pk_fma_f32 v[4:5], v[18:19], v[18:19], v[4:5]
    v_pk_add_f32 v[2:3], v[2:3], v[18:19]
    s_waitcnt vmcnt(16)
    v_dot2_f32_bf16 v20, v24, s20, v7 neg_lo:[0,0,1]
    v_dot2_f32_bf16 v21, v24, s21, v7 neg_lo:[0,0,1]
    v_dot2_f32_bf16 v22, v25, s20, v7 neg_lo:[0,0,1]
    v_dot2_f32_bf16 v23, v25, s21, v7 neg_lo:[0,0,1]
    v_dot2_f32_bf16 v24, v26, s20, v7 neg_lo:[0,0,1]
    v_dot2_f32_bf16 v25, v26, s21, v7 neg_lo:[0,0,1]
    v_dot2_f32_bf16 v26, v27, s20, v7 neg_lo:[0,0,1]
    v_dot2_f32_bf16 v27, v27, s21, v7 neg_lo:[0,0,1]
    v_pk_fma_f32 v[4:5], v[20:21], v[20:21], v[4:5]
    v_pk_add_f32 v[2:3], v[2:3], v[20:21]
    v_pk_fma_f32 v[4:5], v[22:23], v[22:23], v[4:5]
    v_pk_add_f32 v[2:3], v[2:3], v[22:23]
    v_pk_fma_f32 v[4:5], v[24:25], v[24:25], v[4:5]
    v_pk_add_f32 v[2:3], v[2:3], v[24:25]
    v_pk_fma_f32 v[4:5], v[26:27], v[26:27], v[4:5]
    v_pk_add_f32 v[2:3], v[2:3], v[26:27]
    s_waitcnt vmcnt(15)
    v_dot2_f32_bf16 v28, v32, s20, v7 neg_lo:[0,0,1]
    v_dot2_f32_bf16 v29, v32, s21, v7 neg_lo:[0,0,1]
    v_dot2_f32_bf16 v30, v33, s20, v7 neg_lo:[0,0,1]
    v_dot2_f32_bf16 v31, v33, s21, v7 neg_lo:[0,0,1]
    v_dot2_f32_bf16 v32, v34, s20, v7 neg_lo:[0,0,1]
    v_dot2_f32_bf16 v33, v34, s21, v7 neg_lo:[0,0,1]
    v_dot2_f32_bf16 v34, v35, s20, v7 neg_lo:[0,0,1]
    v_dot2_f32_bf16 v35, v35, s21, v7 neg_lo:[0,0,1]
    v_pk_fma_f32 v[4:5], v[28:29], v[28:29], v[4:5]
    v_pk_add_f32 v[2:3], v[2:3], v[28:29]
    v_pk_fma_f32 v[4:5], v[30:31], v[30:31], v[4:5]
    v_pk_add_f32 v[2:3], v[2:3], v[30:31]
    v_pk_fma_f32 v[4:5], v[32:33], v[32:33], v[4:5]
    v_pk_add_f32 v[2:3], v[2:3], v[32:33]
    v_pk_fma_f32 v[4:5], v[34:35], v[34:35], v[4:5]
    v_pk_add_f32 v[2:3], v[2:3], v[34:35]
    s_waitcnt vmcnt(14)
    v_dot2_f32_bf16 v36, v40, s20, v7 neg_lo:[0,0,1]
    v_dot2_f32_bf16 v37, v40, s21, v7 neg_lo:[0,0,1]
    v_dot2_f32_bf16 v38, v41, s20, v7 neg_lo:[0,0,1]
    v_dot2_f32_bf16 v39, v41, s21, v7 neg_lo:[0,0,1]
    v_dot2_f32_bf16 v40, v42, s20, v7 neg_lo:[0,0,1]
    v_dot2_f32_bf16 v41, v42, s21, v7 neg_lo:[0,0,1]
    v_dot2_f32_bf16 v42, v43, s20, v7 neg_lo:[0,0,1]
    v_dot2_f32_bf16 v43, v43, s21, v7 neg_lo:[0,0,1]
    v_pk_fma_f32 v[4:5], v[36:37], v[36:37], v[4:5]
    v_pk_add_f32 v[2:3], v[2:3], v[36:37]
    v_pk_fma_f32 v[4:5], v[38:39], v[38:39], v[4:5]
    v_pk_add_f32 v[2:3], v[2:3], v[38:39]
    v_pk_fma_f32 v[4:5], v[40:41], v[40:41], v[4:5]
    v_pk_add_f32 v[2:3], v[2:3], v[40:41]
    v_pk_fma_f32 v[4:5], v[42:43], v[42:43], v[4:5]
    v_pk_add_f32 v[2:3], v[2:3], v[42:43]
    s_waitcnt vmcnt(13)
    v_dot2_f32_bf16 v44, v48, s20, v7 neg_lo:[0,0,1]
    v_dot2_f32_bf16 v45, v48, s21, v7 neg_lo:[0,0,1]
    v_dot2_f32_bf16 v46, v49, s20, v7 neg_lo:[0,0,1]
    v_dot2_f32_bf16 v47, v49, s21, v7 neg_lo:[0,0,1]
    v_dot2_f32_bf16 v48, v50, s20, v7 neg_lo:[0,0,1]
    v_dot2_f32_bf16 v49, v50, s21, v7 neg_lo:[0,0,1]
    v_dot2_f32_bf16 v50, v51, s20, v7 neg_lo:[0,0,1]
    v_dot2_f32_bf16 v51, v51, s21, v7 neg_lo:[0,0,1]
    v_pk_fma_f32 v[4:5], v[44:45], v[44:45], v[4:5]
    v_pk_add_f32 v[2:3], v[2:3], v[44:45]
    v_pk_fma_f32 v[4:5], v[46:47], v[46:47], v[4:5]
    v_pk_add_f32 v[2:3], v[2:3], v[46:47]
    v_pk_fma_f32 v[4:5], v[48:49], v[48:49], v[4:5]
    v_pk_add_f32 v[2:3], v[2:3], v[48:49]
    v_pk_fma_f32 v[4:5], v[50:51], v[50:51], v[4:5]
    v_pk_add_f32 v[2:3], v[2:3], v[50:51]
    s_waitcnt vmcnt(12)
    v_dot2_f32_bf16 v52, v56, s20, v7 neg_lo:[0,0,1]
    v_dot2_f32_bf16 v53, v56, s21, v7 neg_lo:[0,0,1]
    v_dot2_f32_bf16 v54, v57, s20, v7 neg_lo:[0,0,1]
    v_dot2_f32_bf16 v55, v57, s21, v7 neg_lo:[0,0,1]
    v_dot2_f32_bf16 v56, v58, s20, v7 neg_lo:[0,0,1]
    v_dot2_f32_bf16 v57, v58, s21, v7 neg_lo:[0,0,1]
    v_dot2_f32_bf16 v58, v59, s20, v7 neg_lo:[0,0,1]
    v_dot2_f32_bf16 v59, v59, s21, v7 neg_lo:[0,0,1]
    v_pk_fma_f32 v[4:5], v[52:53], v[52:53], v[4:5]
    v_pk_add_f32 v[2:3], v[2:3], v[52:53]
    v_pk_fma_f32 v[4:5], v[54:55], v[54:55], v[4:5]
    v_pk_add_f32 v[2:3], v[2:3], v[54:55]
    v_pk_fma_f32 v[4:5], v[56:57], v[56:57], v[4:5]
    v_pk_add_f32 v[2:3], v[2:3], v[56:57]
    v_pk_fma_f32 v[4:5], v[58:59], v[58:59], v[4:5]
    v_pk_add_f32 v[2:3], v[2:3], v[58:59]
    s_waitcnt vmcnt(11)
    v_dot2_f32_bf16 v60, v64, s20, v7 neg_lo:[0,0,1]
    v_dot2_f32_bf16 v61, v64, s21, v7 neg_lo:[0,0,1]
    v_dot2_f32_bf16 v62, v65, s20, v7 neg_lo:[0,0,1]
    v_dot2_f32_bf16 v63, v65, s21, v7 neg_lo:[0,0,1]
    v_dot2_f32_bf16 v64, v66, s20, v7 neg_lo:[0,0,1]
    v_dot2_f32_bf16 v65, v66, s21, v7 neg_lo:[0,0,1]
    v_dot2_f32_bf16 v66, v67, s20, v7 neg_lo:[0,0,1]
    v_dot2_f32_bf16 v67, v67, s21, v7 neg_lo:[0,0,1]
    v_pk_fma_f32 v[4:5], v[60:61], v[60:61], v[4:5]
    v_pk_add_f32 v[2:3], v[2:3], v[60:61]
    v_pk_fma_f32 v[4:5], v[62:63], v[62:63], v[4:5]
    v_pk_add_f32 v[2:3], v[2:3], v[62:63]
    v_pk_fma_f32 v[4:5], v[64:65], v[64:65], v[4:5]
    v_pk_add_f32 v[2:3], v[2:3], v[64:65]
    v_pk_fma_f32 v[4:5], v[66:67], v[66:67], v[4:5]
    v_pk_add_f32 v[2:3], v[2:3], v[66:67]
    s_waitcnt vmcnt(10)
    v_dot2_f32_bf16 v68, v72, s20, v7 neg_lo:[0,0,1]
    v_dot2_f32_bf16 v69, v72, s21, v7 neg_lo:[0,0,1]
    v_dot2_f32_bf16 v70, v73, s20, v7 neg_lo:[0,0,1]
    v_dot2_f32_bf16 v71, v73, s21, v7 neg_lo:[0,0,1]
    v_dot2_f32_bf16 v72, v74, s20, v7 neg_lo:[0,0,1]
    v_dot2_f32_bf16 v73, v74, s21, v7 neg_lo:[0,0,1]
    v_dot2_f32_bf16 v74, v75, s20, v7 neg_lo:[0,0,1]
    v_dot2_f32_bf16 v75, v75, s21, v7 neg_lo:[0,0,1]
    v_pk_fma_f32 v[4:5], v[68:69], v[68:69], v[4:5]
    v_pk_add_f32 v[2:3], v[2:3], v[68:69]
    v_pk_fma_f32 v[4:5], v[70:71], v[70:71], v[4:5]
    v_pk_add_f32 v[2:3], v[2:3], v[70:71]
    v_pk_fma_f32 v[4:5], v[72:73], v[72:73], v[4:5]
    v_pk_add_f32 v[2:3], v[2:3], v[72:73]
    v_pk_fma_f32 v[4:5], v[74:75], v[74:75], v[4:5]
    v_pk_add_f32 v[2:3], v[2:3], v[74:75]
    s_waitcnt vmcnt(9)
    v_dot2_f32_bf16 v76, v80, s20, v7 neg_lo:[0,0,1]
    v_dot2_f32_bf16 v77, v80, s21, v7 neg_lo:[0,0,1]
    v_dot2_f32_bf16 v78, v81, s20, v7 neg_lo:[0,0,1]
    v_dot2_f32_bf16 v79, v81, s21, v7 neg_lo:[0,0,1]
    v_dot2_f32_bf16 v80, v82, s20, v7 neg_lo:[0,0,1]
    v_dot2_f32_bf16 v81, v82, s21, v7 neg_lo:[0,0,1]
    v_dot2_f32_bf16 v82, v83, s20, v7 neg_lo:[0,0,1]
    v_dot2_f32_bf16 v83, v83, s21, v7 neg_lo:[0,0,1]
    v_pk_fma_f32 v[4:5], v[76:77], v[76:77], v[4:5]
    v_pk_add_f32 v[2:3], v[2:3], v[76:77]
    v_pk_fma_f32 v[4:5], v[78:79], v[78:79], v[4:5]
    v_pk_add_f32 v[2:3], v[2:3], v[78:79]
    v_pk_fma_f32 v[4:5], v[80:81], v[80:81], v[4:5]
    v_pk_add_f32 v[2:3], v[2:3], v[80:81]
    v_pk_fma_f32 v[4:5], v[82:83], v[82:83], v[4:5]
    v_pk_add_f32 v[2:3], v[2:3], v[82:83]
    s_waitcnt lgkmcnt(0)
    s_lshl_b32 s50, s28, 16
    s_and_b32 s51, s28, 0xffff0000
    s_lshl_b32 s52, s29, 16
    s_and_b32 s53, s29, 0xffff0000
    s_lshl_b32 s54, s30, 16
    s_and_b32 s55, s30, 0xffff0000
    s_lshl_b32 s56, s31, 16
    s_and_b32 s57, s31, 0xffff0000
    s_lshl_b32 s58, s32, 16
    s_and_b32 s59, s32, 0xffff0000
    s_lshl_b32 s60, s33, 16
    s_and_b32 s61, s33, 0xffff0000
    s_lshl_b32 s62, s34, 16
    s_and_b32 s63, s34, 0xffff0000
    s_lshl_b32 s64, s35, 16
    s_and_b32 s65, s35, 0xffff0000
    s_lshl_b32 s66, s36, 16
    s_and_b32 s67, s36, 0xffff0000
    s_lshl_b32 s68, s40, 16
    s_and_b32 s69, s40, 0xffff0000
    s_lshl_b32 s70, s41, 16
    s_and_b32 s71, s41, 0xffff0000
    s_lshl_b32 s72, s42, 16
    s_and_b32 s73, s42, 0xffff0000
    s_lshl_b32 s74, s43, 16
    s_and_b32 s75, s43, 0xffff0000
    s_lshl_b32 s76, s44, 16
    s_and_b32 s77, s44, 0xffff0000
    s_lshl_b32 s78, s45, 16
    s_and_b32 s79, s45, 0xffff0000
    s_lshl_b32 s80, s46, 16
    s_and_b32 s81, s46, 0xffff0000
    s_lshl_b32 s82, s47, 16
    s_and_b32 s83, s47, 0xffff0000
    s_lshl_b32 s84, s48, 16
    s_and_b32 s85, s48, 0xffff0000
    s_waitcnt vmcnt(8)
    v_dot2_f32_bf16 v84, v88, s20, v7 neg_lo:[0,0,1]
    v_dot2_f32_bf16 v85, v88, s21, v7 neg_lo:[0,0,1]
    v_dot2_f32_bf16 v86, v89, s20, v7 neg_lo:[0,0,1]
    v_dot2_f32_bf16 v87, v89, s21, v7 neg_lo:[0,0,1]
    v_dot2_f32_bf16 v88, v90, s20, v7 neg_lo:[0,0,1]
    v_dot2_f32_bf16 v89, v90, s21, v7 neg_lo:[0,0,1]
    v_dot2_f32_bf16 v90, v91, s20, v7 neg_lo:[0,0,1]
    v_dot2_f32_bf16 v91, v91, s21, v7 neg_lo:[0,0,1]
    v_pk_fma_f32 v[4:5], v[84:85], v[84:85], v[4:5]
    v_pk_add_f32 v[2:3], v[2:3], v[84:85]
    v_pk_fma_f32 v[4:5], v[86:87], v[86:87], v[4:5]
    v_pk_add_f32 v[2:3], v[2:3], v[86:87]
    v_pk_fma_f32 v[4:5], v[88:89], v[88:89], v[4:5]
    v_pk_add_f32 v[2:3], v[2:3], v[88:89]
    v_pk_fma_f32 v[4:5], v[90:91], v[90:91], v[4:5]
    v_pk_add_f32 v[2:3], v[2:3], v[90:91]
    s_waitcnt vmcnt(7)
    v_dot2_f32_bf16 v92, v96, s20, v7 neg_lo:[0,0,1]
    v_dot2_f32_bf16 v93, v96, s21, v7 neg_lo:[0,0,1]
    v_dot2_f32_bf16 v94, v97, s20, v7 neg_lo:[0,0,1]
    v_dot2_f32_bf16 v95, v97, s21, v7 neg_lo:[0,0,1]
    v_dot2_f32_bf16 v96, v98, s20, v7 neg_lo:[0,0,1]
    v_dot2_f32_bf16 v97, v98, s21, v7 neg_lo:[0,0,1]
    v_dot2_f32_bf16 v98, v99, s20, v7 neg_lo:[0,0,1]
    v_dot2_f32_bf16 v99, v99, s21, v7 neg_lo:[0,0,1]
    v_pk_fma_f32 v[4:5], v[92:93], v[92:93], v[4:5]
    v_pk_add_f32 v[2:3], v[2:3], v[92:93]
    v_pk_fma_f32 v[4:5], v[94:95], v[94:95], v[4:5]
    v_pk_add_f32 v[2:3], v[2:3], v[94:95]
    v_pk_fma_f32 v[4:5], v[96:97], v[96:97], v[4:5]
    v_pk_add_f32 v[2:3], v[2:3], v[96:97]
    v_pk_fma_f32 v[4:5], v[98:99], v[98:99], v[4:5]
    v_pk_add_f32 v[2:3], v[2:3], v[98:99]
    s_waitcnt vmcnt(6)
    v_dot2_f32_bf16 v100, v104, s20, v7 neg_lo:[0,0,1]
    v_dot2_f32_bf16 v101, v104, s21, v7 neg_lo:[0,0,1]
    v_dot2_f32_bf16 v102, v105, s20, v7 neg_lo:[0,0,1]
    v_dot2_f32_bf16 v103, v105, s21, v7 neg_lo:[0,0,1]
    v_dot2_f32_bf16 v104, v106, s20, v7 neg_lo:[0,0,1]
    v_dot2_f32_bf16 v105, v106, s21, v7 neg_lo:[0,0,1]
    v_dot2_f32_bf16 v106, v107, s20, v7 neg_lo:[0,0,1]
    v_dot2_f32_bf16 v107, v107, s21, v7 neg_lo:[0,0,1]
    v_pk_fma_f32 v[4:5], v[100:101], v[100:101], v[4:5]
    v_pk_add_f32 v[2:3], v[2:3], v[100:101]
    v_pk_fma_f32 v[4:5], v[102:103], v[102:103], v[4:5]
    v_pk_add_f32 v[2:3], v[2:3], v[102:103]
    v_pk_fma_f32 v[4:5], v[104:105], v[104:105], v[4:5]
    v_pk_add_f32 v[2:3], v[2:3], v[104:105]
    v_pk_fma_f32 v[4:5], v[106:107], v[106:107], v[4:5]
    v_pk_add_f32 v[2:3], v[2:3], v[106:107]
    s_waitcnt vmcnt(5)
    v_dot2_f32_bf16 v108, v112, s20, v7 neg_lo:[0,0,1]
    v_dot2_f32_bf16 v109, v112, s21, v7 neg_lo:[0,0,1]
    v_dot2_f32_bf16 v110, v113, s20, v7 neg_lo:[0,0,1]
    v_dot2_f32_bf16 v111, v113, s21, v7 neg_lo:[0,0,1]
    v_dot2_f32_bf16 v112, v114, s20, v7 neg_lo:[0,0,1]
    v_dot2_f32_bf16 v113, v114, s21, v7 neg_lo:[0,0,1]
    v_dot2_f32_bf16 v114, v115, s20, v7 neg_lo:[0,0,1]
    v_dot2_f32_bf16 v115, v115, s21, v7 neg_lo:[0,0,1]
    v_pk_fma_f32 v[4:5], v[108:109], v[108:109], v[4:5]
    v_pk_add_f32 v[2:3], v[2:3], v[108:109]
    v_pk_fma_f32 v[4:5], v[110:111], v[110:111], v[4:5]
    v_pk_add_f32 v[2:3], v[2:3], v[110:111]
    v_pk_fma_f32 v[4:5], v[112:113], v[112:113], v[4:5]
    v_pk_add_f32 v[2:3], v[2:3], v[112:113]
    v_pk_fma_f32 v[4:5], v[114:115], v[114:115], v[4:5]
    v_pk_add_f32 v[2:3], v[2:3], v[114:115]
    s_waitcnt vmcnt(4)
    v_dot2_f32_bf16 v116, v120, s20, v7 neg_lo:[0,0,1]
    v_dot2_f32_bf16 v117, v120, s21, v7 neg_lo:[0,0,1]
    v_dot2_f32_bf16 v118, v121, s20, v7 neg_lo:[0,0,1]
    v_dot2_f32_bf16 v119, v121, s21, v7 neg_lo:[0,0,1]
    v_dot2_f32_bf16 v120, v122, s20, v7 neg_lo:[0,0,1]
    v_dot2_f32_bf16 v121, v122, s21, v7 neg_lo:[0,0,1]
    v_dot2_f32_bf16 v122, v123, s20, v7 neg_lo:[0,0,1]
    v_dot2_f32_bf16 v123, v123, s21, v7 neg_lo:[0,0,1]
    v_pk_fma_f32 v[4:5], v[116:117], v[116:117], v[4:5]
    v_pk_add_f32 v[2:3], v[2:3], v[116:117]
    v_pk_fma_f32 v[4:5], v[118:119], v[118:119], v[4:5]
    v_pk_add_f32 v[2:3], v[2:3], v[118:119]
    v_pk_fma_f32 v[4:5], v[120:121], v[120:121], v[4:5]
    v_pk_add_f32 v[2:3], v[2:3], v[120:121]
    v_pk_fma_f32 v[4:5], v[122:123], v[122:123], v[4:5]
    v_pk_add_f32 v[2:3], v[2:3], v[122:123]
    s_waitcnt vmcnt(3)
    v_dot2_f32_bf16 v124, v128, s20, v7 neg_lo:[0,0,1]
    v_dot2_f32_bf16 v125, v128, s21, v7 neg_lo:[0,0,1]
    v_dot2_f32_bf16 v126, v129, s20, v7 neg_lo:[0,0,1]
    v_dot2_f32_bf16 v127, v129, s21, v7 neg_lo:[0,0,1]
    v_dot2_f32_bf16 v128, v130, s20, v7 neg_lo:[0,0,1]
    v_dot2_f32_bf16 v129, v130, s21, v7 neg_lo:[0,0,1]
    v_dot2_f32_bf16 v130, v131, s20, v7 neg_lo:[0,0,1]
    v_dot2_f32_bf16 v131, v131, s21, v7 neg_lo:[0,0,1]
    v_pk_fma_f32 v[4:5], v[124:125], v[124:125], v[4:5]
    v_pk_add_f32 v[2:3], v[2:3], v[124:125]
    v_pk_fma_f32 v[4:5], v[126:127], v[126:127], v[4:5]
    v_pk_add_f32 v[2:3], v[2:3], v[126:127]
    v_pk_fma_f32 v[4:5], v[128:129], v[128:129], v[4:5]
    v_pk_add_f32 v[2:3], v[2:3], v[128:129]
    v_pk_fma_f32 v[4:5], v[130:131], v[130:131], v[4:5]
    v_pk_add_f32 v[2:3], v[2:3], v[130:131]
    s_waitcnt vmcnt(2)
    v_dot2_f32_bf16 v132, v136, s20, v7 neg_lo:[0,0,1]
    v_dot2_f32_bf16 v133, v136, s21, v7 neg_lo:[0,0,1]
    v_dot2_f32_bf16 v134, v137, s20, v7 neg_lo:[0,0,1]
    v_dot2_f32_bf16 v135, v137, s21, v7 neg_lo:[0,0,1]
    v_dot2_f32_bf16 v136, v138, s20, v7 neg_lo:[0,0,1]
    v_dot2_f32_bf16 v137, v138, s21, v7 neg_lo:[0,0,1]
    v_dot2_f32_bf16 v138, v139, s20, v7 neg_lo:[0,0,1]
    v_dot2_f32_bf16 v139, v139, s21, v7 neg_lo:[0,0,1]
    v_pk_fma_f32 v[4:5], v[132:133], v[132:133], v[4:5]
    v_pk_add_f32 v[2:3], v[2:3], v[132:133]
    v_pk_fma_f32 v[4:5], v[134:135], v[134:135], v[4:5]
    v_pk_add_f32 v[2:3], v[2:3], v[134:135]
    v_pk_fma_f32 v[4:5], v[136:137], v[136:137], v[4:5]
    v_pk_add_f32 v[2:3], v[2:3], v[136:137]
    v_pk_fma_f32 v[4:5], v[138:139], v[138:139], v[4:5]
    v_pk_add_f32 v[2:3], v[2:3], v[138:139]
    s_waitcnt vmcnt(1)
    v_dot2_f32_bf16 v140, v144, s20, v7 neg_lo:[0,0,1]
    v_dot2_f32_bf16 v141, v144, s21, v7 neg_lo:[0,0,1]
    v_dot2_f32_bf16 v142, v145, s20, v7 neg_lo:[0,0,1]
    v_dot2_f32_bf16 v143, v145, s21, v7 neg_lo:[0,0,1]
    v_dot2_f32_bf16 v144, v146, s20, v7 neg_lo:[0,0,1]
    v_dot2_f32_bf16 v145, v146, s21, v7 neg_lo:[0,0,1]
    v_dot2_f32_bf16 v146, v147, s20, v7 neg_lo:[0,0,1]
    v_dot2_f32_bf16 v147, v147, s21, v7 neg_lo:[0,0,1]
    v_pk_fma_f32 v[4:5], v[140:141], v[140:141], v[4:5]
    v_pk_add_f32 v[2:3], v[2:3], v[140:141]
    v_pk_fma_f32 v[4:5], v[142:143], v[142:143], v[4:5]
    v_pk_add_f32 v[2:3], v[2:3], v[142:143]
    v_pk_fma_f32 v[4:5], v[144:145], v[144:145], v[4:5]
    v_pk_add_f32 v[2:3], v[2:3], v[144:145]
    v_pk_fma_f32 v[4:5], v[146:147], v[146:147], v[4:5]
    v_pk_add_f32 v[2:3], v[2:3], v[146:147]
    s_waitcnt vmcnt(0)
    v_dot2_f32_bf16 v148, v152, s20, v7 neg_lo:[0,0,1]
    v_dot2_f32_bf16 v149, v152, s21, v7 neg_lo:[0,0,1]
    v_dot2_f32_bf16 v150, v153, s20, v7 neg_lo:[0,0,1]
    v_dot2_f32_bf16 v151, v153, s21, v7 neg_lo:[0,0,1]
    v_dot2_f32_bf16 v152, v154, s20, v7 neg_lo:[0,0,1]
    v_dot2_f32_bf16 v153, v154, s21, v7 neg_lo:[0,0,1]
    v_dot2_f32_bf16 v154, v155, s20, v7 neg_lo:[0,0,1]
    v_dot2_f32_bf16 v155, v155, s21, v7 neg_lo:[0,0,1]
    v_pk_fma_f32 v[4:5], v[148:149], v[148:149], v[4:5]
    v_pk_add_f32 v[2:3], v[2:3], v[148:149]
    v_pk_fma_f32 v[4:5], v[150:151], v[150:151], v[4:5]
    v_pk_add_f32 v[2:3], v[2:3], v[150:151]
    v_pk_fma_f32 v[4:5], v[152:153], v[152:153], v[4:5]
    v_pk_add_f32 v[2:3], v[2:3], v[152:153]
    v_pk_fma_f32 v[4:5], v[154:155], v[154:155], v[4:5]
    v_pk_add_f32 v[2:3], v[2:3], v[154:155]
    v_add_f32 v3, v2, v3
    v_add_f32 v4, v4, v5
    s_nop 0
    v_add_f32_dpp v2, v3, v3 row_shr:1 row_mask:0xf bank_mask:0xf bound_ctrl:1
    v_add_f32_dpp v3, v4, v4 row_shr:1 row_mask:0xf bank_mask:0xf bound_ctrl:1
    s_nop 0
    v_add_f32_dpp v2, v2, v2 row_shr:2 row_mask:0xf bank_mask:0xf
    v_add_f32_dpp v3, v3, v3 row_shr:2 row_mask:0xf bank_mask:0xf
    s_nop 0
    v_add_f32_dpp v2, v2, v2 row_shr:4 row_mask:0xf bank_mask:0xf
    v_add_f32_dpp v3, v3, v3 row_shr:4 row_mask:0xf bank_mask:0xf
    s_nop 0
    v_add_f32_dpp v2, v2, v2 row_shr:8 row_mask:0xf bank_mask:0xf
    v_add_f32_dpp v3, v3, v3 row_shr:8 row_mask:0xf bank_mask:0xf
    s_nop 0
    v_add_f32_dpp v2, v2, v2 row_bcast:15 row_mask:0xa bank_mask:0xf
    v_add_f32_dpp v3, v3, v3 row_bcast:15 row_mask:0xa bank_mask:0xf
    s_nop 0
    v_add_f32_dpp v2, v2, v2 row_bcast:31 row_mask:0xc bank_mask:0xf
    v_add_f32_dpp v3, v3, v3 row_bcast:31 row_mask:0xc bank_mask:0xf
    v_readlane_b32 s18, v2, 63
    v_readlane_b32 s19, v3, 63
    s_nop 1
    v_pk_fma_f32 v[2:3], s[18:19], v[6:7], v[8:9] op_sel_hi:[1,0,1]
    v_fma_f32 v3, -v2, v2, v3
    v_rsq_f32 v3, v3
    s_nop 0
    v_pk_mul_f32 v[8:9], v[2:3], s[50:51] op_sel:[1,0] op_sel_hi:[1,1]
    v_pk_fma_f32 v[10:11], v[8:9], v[2:3], s[68:69] op_sel:[0,0,0] op_sel_hi:[1,0,1] neg_lo:[0,1,0] neg_hi:[0,1,0]
    v_pk_fma_f32 v[12:13], v[12:13], v[8:9], v[10:11] op_sel:[0,0,0] op_sel_hi:[1,0,0]
    v_pk_fma_f32 v[14:15], v[14:15], v[8:9], v[10:11] op_sel:[0,0,0] op_sel_hi:[1,0,0]
    v_pk_fma_f32 v[16:17], v[16:17], v[8:9], v[10:11] op_sel:[0,0,0] op_sel_hi:[1,0,0]
    v_pk_fma_f32 v[18:19], v[18:19], v[8:9], v[10:11] op_sel:[0,0,0] op_sel_hi:[1,0,0]
    v_cvt_pk_bf16_f32 v12, v12, v13
    v_cvt_pk_bf16_f32 v13, v14, v15
    v_cvt_pk_bf16_f32 v14, v16, v17
    v_cvt_pk_bf16_f32 v15, v18, v19
    buffer_store_dwordx4 v[12:15], v0, s[8:11], s3 offen nt
    v_pk_fma_f32 v[20:21], v[20:21], v[8:9], v[10:11] op_sel:[0,1,1] op_sel_hi:[1,1,1]
    v_pk_fma_f32 v[22:23], v[22:23], v[8:9], v[10:11] op_sel:[0,1,1] op_sel_hi:[1,1,1]
    v_pk_fma_f32 v[24:25], v[24:25], v[8:9], v[10:11] op_sel:[0,1,1] op_sel_hi:[1,1,1]
    v_pk_fma_f32 v[26:27], v[26:27], v[8:9], v[10:11] op_sel:[0,1,1] op_sel_hi:[1,1,1]
    v_cvt_pk_bf16_f32 v20, v20, v21
    v_cvt_pk_bf16_f32 v21, v22, v23
    v_cvt_pk_bf16_f32 v22, v24, v25
    v_cvt_pk_bf16_f32 v23, v26, v27
    buffer_store_dwordx4 v[20:23], v0, s[8:11], s3 offen offset:1024 nt
    v_pk_mul_f32 v[8:9], v[2:3], s[52:53] op_sel:[1,0] op_sel_hi:[1,1]
    v_pk_fma_f32 v[10:11], v[8:9], v[2:3], s[70:71] op_sel:[0,0,0] op_sel_hi:[1,0,1] neg_lo:[0,1,0] neg_hi:[0,1,0]
    v_pk_fma_f32 v[28:29], v[28:29], v[8:9], v[10:11] op_sel:[0,0,0] op_sel_hi:[1,0,0]
    v_pk_fma_f32 v[30:31], v[30:31], v[8:9], v[10:11] op_sel:[0,0,0] op_sel_hi:[1,0,0]
    v_pk_fma_f32 v[32:33], v[32:33], v[8:9], v[10:11] op_sel:[0,0,0] op_sel_hi:[1,0,0]
    v_pk_fma_f32 v[34:35], v[34:35], v[8:9], v[10:11] op_sel:[0,0,0] op_sel_hi:[1,0,0]
    v_cvt_pk_bf16_f32 v28, v28, v29
    v_cvt_pk_bf16_f32 v29, v30, v31
    v_cvt_pk_bf16_f32 v30, v32, v33
    v_cvt_pk_bf16_f32 v31, v34, v35
    buffer_store_dwordx4 v[28:31], v0, s[8:11], s3 offen offset:2048 nt
    v_pk_fma_f32 v[36:37], v[36:37], v[8:9], v[10:11] op_sel:[0,1,1] op_sel_hi:[1,1,1]
    v_pk_fma_f32 v[38:39], v[38:39], v[8:9], v[10:11] op_sel:[0,1,1] op_sel_hi:[1,1,1]
    v_pk_fma_f32 v[40:41], v[40:41], v[8:9], v[10:11] op_sel:[0,1,1] op_sel_hi:[1,1,1]
    v_pk_fma_f32 v[42:43], v[42:43], v[8:9], v[10:11] op_sel:[0,1,1] op_sel_hi:[1,1,1]
    v_cvt_pk_bf16_f32 v36, v36, v37
    v_cvt_pk_bf16_f32 v37, v38, v39
    v_cvt_pk_bf16_f32 v38, v40, v41
    v_cvt_pk_bf16_f32 v39, v42, v43
    buffer_store_dwordx4 v[36:39], v0, s[8:11], s3 offen offset:3072 nt
    v_pk_mul_f32 v[8:9], v[2:3], s[54:55] op_sel:[1,0] op_sel_hi:[1,1]
    v_pk_fma_f32 v[10:11], v[8:9], v[2:3], s[72:73] op_sel:[0,0,0] op_sel_hi:[1,0,1] neg_lo:[0,1,0] neg_hi:[0,1,0]
    v_pk_fma_f32 v[44:45], v[44:45], v[8:9], v[10:11] op_sel:[0,0,0] op_sel_hi:[1,0,0]
    v_pk_fma_f32 v[46:47], v[46:47], v[8:9], v[10:11] op_sel:[0,0,0] op_sel_hi:[1,0,0]
    v_pk_fma_f32 v[48:49], v[48:49], v[8:9], v[10:11] op_sel:[0,0,0] op_sel_hi:[1,0,0]
    v_pk_fma_f32 v[50:51], v[50:51], v[8:9], v[10:11] op_sel:[0,0,0] op_sel_hi:[1,0,0]
    v_cvt_pk_bf16_f32 v44, v44, v45
    v_cvt_pk_bf16_f32 v45, v46, v47
    v_cvt_pk_bf16_f32 v46, v48, v49
    v_cvt_pk_bf16_f32 v47, v50, v51
    buffer_store_dwordx4 v[44:47], v0, s[8:11], s22 offen nt
    v_pk_fma_f32 v[52:53], v[52:53], v[8:9], v[10:11] op_sel:[0,1,1] op_sel_hi:[1,1,1]
    v_pk_fma_f32 v[54:55], v[54:55], v[8:9], v[10:11] op_sel:[0,1,1] op_sel_hi:[1,1,1]
    v_pk_fma_f32 v[56:57], v[56:57], v[8:9], v[10:11] op_sel:[0,1,1] op_sel_hi:[1,1,1]
    v_pk_fma_f32 v[58:59], v[58:59], v[8:9], v[10:11] op_sel:[0,1,1] op_sel_hi:[1,1,1]
    v_cvt_pk_bf16_f32 v52, v52, v53
    v_cvt_pk_bf16_f32 v53, v54, v55
    v_cvt_pk_bf16_f32 v54, v56, v57
    v_cvt_pk_bf16_f32 v55, v58, v59
    buffer_store_dwordx4 v[52:55], v0, s[8:11], s22 offen offset:1024 nt
    v_pk_mul_f32 v[8:9], v[2:3], s[56:57] op_sel:[1,0] op_sel_hi:[1,1]
    v_pk_fma_f32 v[10:11], v[8:9], v[2:3], s[74:75] op_sel:[0,0,0] op_sel_hi:[1,0,1] neg_lo:[0,1,0] neg_hi:[0,1,0]
    v_pk_fma_f32 v[60:61], v[60:61], v[8:9], v[10:11] op_sel:[0,0,0] op_sel_hi:[1,0,0]
    v_pk_fma_f32 v[62:63], v[62:63], v[8:9], v[10:11] op_sel:[0,0,0] op_sel_hi:[1,0,0]
    v_pk_fma_f32 v[64:65], v[64:65], v[8:9], v[10:11] op_sel:[0,0,0] op_sel_hi:[1,0,0]
    v_pk_fma_f32 v[66:67], v[66:67], v[8:9], v[10:11] op_sel:[0,0,0] op_sel_hi:[1,0,0]
    v_cvt_pk_bf16_f32 v60, v60, v61
    v_cvt_pk_bf16_f32 v61, v62, v63
    v_cvt_pk_bf16_f32 v62, v64, v65
    v_cvt_pk_bf16_f32 v63, v66, v67
    buffer_store_dwordx4 v[60:63], v0, s[8:11], s22 offen offset:2048 nt
    v_pk_fma_f32 v[68:69], v[68:69], v[8:9], v[10:11] op_sel:[0,1,1] op_sel_hi:[1,1,1]
    v_pk_fma_f32 v[70:71], v[70:71], v[8:9], v[10:11] op_sel:[0,1,1] op_sel_hi:[1,1,1]
    v_pk_fma_f32 v[72:73], v[72:73], v[8:9], v[10:11] op_sel:[0,1,1] op_sel_hi:[1,1,1]
    v_pk_fma_f32 v[74:75], v[74:75], v[8:9], v[10:11] op_sel:[0,1,1] op_sel_hi:[1,1,1]
    v_cvt_pk_bf16_f32 v68, v68, v69
    v_cvt_pk_bf16_f32 v69, v70, v71
    v_cvt_pk_bf16_f32 v70, v72, v73
    v_cvt_pk_bf16_f32 v71, v74, v75
    buffer_store_dwordx4 v[68:71], v0, s[8:11], s22 offen offset:3072 nt
    v_pk_mul_f32 v[8:9], v[2:3], s[58:59] op_sel:[1,0] op_sel_hi:[1,1]
    v_pk_fma_f32 v[10:11], v[8:9], v[2:3], s[76:77] op_sel:[0,0,0] op_sel_hi:[1,0,1] neg_lo:[0,1,0] neg_hi:[0,1,0]
    v_pk_fma_f32 v[76:77], v[76:77], v[8:9], v[10:11] op_sel:[0,0,0] op_sel_hi:[1,0,0]
    v_pk_fma_f32 v[78:79], v[78:79], v[8:9], v[10:11] op_sel:[0,0,0] op_sel_hi:[1,0,0]
    v_pk_fma_f32 v[80:81], v[80:81], v[8:9], v[10:11] op_sel:[0,0,0] op_sel_hi:[1,0,0]
    v_pk_fma_f32 v[82:83], v[82:83], v[8:9], v[10:11] op_sel:[0,0,0] op_sel_hi:[1,0,0]
    v_cvt_pk_bf16_f32 v76, v76, v77
    v_cvt_pk_bf16_f32 v77, v78, v79
    v_cvt_pk_bf16_f32 v78, v80, v81
    v_cvt_pk_bf16_f32 v79, v82, v83
    buffer_store_dwordx4 v[76:79], v0, s[8:11], s23 offen nt
    v_pk_fma_f32 v[84:85], v[84:85], v[8:9], v[10:11] op_sel:[0,1,1] op_sel_hi:[1,1,1]
    v_pk_fma_f32 v[86:87], v[86:87], v[8:9], v[10:11] op_sel:[0,1,1] op_sel_hi:[1,1,1]
    v_pk_fma_f32 v[88:89], v[88:89], v[8:9], v[10:11] op_sel:[0,1,1] op_sel_hi:[1,1,1]
    v_pk_fma_f32 v[90:91], v[90:91], v[8:9], v[10:11] op_sel:[0,1,1] op_sel_hi:[1,1,1]
    v_cvt_pk_bf16_f32 v84, v84, v85
    v_cvt_pk_bf16_f32 v85, v86, v87
    v_cvt_pk_bf16_f32 v86, v88, v89
    v_cvt_pk_bf16_f32 v87, v90, v91
    buffer_store_dwordx4 v[84:87], v0, s[8:11], s23 offen offset:1024 nt
    v_pk_mul_f32 v[8:9], v[2:3], s[60:61] op_sel:[1,0] op_sel_hi:[1,1]
    v_pk_fma_f32 v[10:11], v[8:9], v[2:3], s[78:79] op_sel:[0,0,0] op_sel_hi:[1,0,1] neg_lo:[0,1,0] neg_hi:[0,1,0]
    v_pk_fma_f32 v[92:93], v[92:93], v[8:9], v[10:11] op_sel:[0,0,0] op_sel_hi:[1,0,0]
    v_pk_fma_f32 v[94:95], v[94:95], v[8:9], v[10:11] op_sel:[0,0,0] op_sel_hi:[1,0,0]
    v_pk_fma_f32 v[96:97], v[96:97], v[8:9], v[10:11] op_sel:[0,0,0] op_sel_hi:[1,0,0]
    v_pk_fma_f32 v[98:99], v[98:99], v[8:9], v[10:11] op_sel:[0,0,0] op_sel_hi:[1,0,0]
    v_cvt_pk_bf16_f32 v92, v92, v93
    v_cvt_pk_bf16_f32 v93, v94, v95
    v_cvt_pk_bf16_f32 v94, v96, v97
    v_cvt_pk_bf16_f32 v95, v98, v99
    buffer_store_dwordx4 v[92:95], v0, s[8:11], s23 offen offset:2048 nt
    v_pk_fma_f32 v[100:101], v[100:101], v[8:9], v[10:11] op_sel:[0,1,1] op_sel_hi:[1,1,1]
    v_pk_fma_f32 v[102:103], v[102:103], v[8:9], v[10:11] op_sel:[0,1,1] op_sel_hi:[1,1,1]
    v_pk_fma_f32 v[104:105], v[104:105], v[8:9], v[10:11] op_sel:[0,1,1] op_sel_hi:[1,1,1]
    v_pk_fma_f32 v[106:107], v[106:107], v[8:9], v[10:11] op_sel:[0,1,1] op_sel_hi:[1,1,1]
    v_cvt_pk_bf16_f32 v100, v100, v101
    v_cvt_pk_bf16_f32 v101, v102, v103
    v_cvt_pk_bf16_f32 v102, v104, v105
    v_cvt_pk_bf16_f32 v103, v106, v107
    buffer_store_dwordx4 v[100:103], v0, s[8:11], s23 offen offset:3072 nt
    v_pk_mul_f32 v[8:9], v[2:3], s[62:63] op_sel:[1,0] op_sel_hi:[1,1]
    v_pk_fma_f32 v[10:11], v[8:9], v[2:3], s[80:81] op_sel:[0,0,0] op_sel_hi:[1,0,1] neg_lo:[0,1,0] neg_hi:[0,1,0]
    v_pk_fma_f32 v[108:109], v[108:109], v[8:9], v[10:11] op_sel:[0,0,0] op_sel_hi:[1,0,0]
    v_pk_fma_f32 v[110:111], v[110:111], v[8:9], v[10:11] op_sel:[0,0,0] op_sel_hi:[1,0,0]
    v_pk_fma_f32 v[112:113], v[112:113], v[8:9], v[10:11] op_sel:[0,0,0] op_sel_hi:[1,0,0]
    v_pk_fma_f32 v[114:115], v[114:115], v[8:9], v[10:11] op_sel:[0,0,0] op_sel_hi:[1,0,0]
    v_cvt_pk_bf16_f32 v108, v108, v109
    v_cvt_pk_bf16_f32 v109, v110, v111
    v_cvt_pk_bf16_f32 v110, v112, v113
    v_cvt_pk_bf16_f32 v111, v114, v115
    buffer_store_dwordx4 v[108:111], v0, s[8:11], s24 offen nt
    v_pk_fma_f32 v[116:117], v[116:117], v[8:9], v[10:11] op_sel:[0,1,1] op_sel_hi:[1,1,1]
    v_pk_fma_f32 v[118:119], v[118:119], v[8:9], v[10:11] op_sel:[0,1,1] op_sel_hi:[1,1,1]
    v_pk_fma_f32 v[120:121], v[120:121], v[8:9], v[10:11] op_sel:[0,1,1] op_sel_hi:[1,1,1]
    v_pk_fma_f32 v[122:123], v[122:123], v[8:9], v[10:11] op_sel:[0,1,1] op_sel_hi:[1,1,1]
    v_cvt_pk_bf16_f32 v116, v116, v117
    v_cvt_pk_bf16_f32 v117, v118, v119
    v_cvt_pk_bf16_f32 v118, v120, v121
    v_cvt_pk_bf16_f32 v119, v122, v123
    buffer_store_dwordx4 v[116:119], v0, s[8:11], s24 offen offset:1024 nt
    v_pk_mul_f32 v[8:9], v[2:3], s[64:65] op_sel:[1,0] op_sel_hi:[1,1]
    v_pk_fma_f32 v[10:11], v[8:9], v[2:3], s[82:83] op_sel:[0,0,0] op_sel_hi:[1,0,1] neg_lo:[0,1,0] neg_hi:[0,1,0]
    v_pk_fma_f32 v[124:125], v[124:125], v[8:9], v[10:11] op_sel:[0,0,0] op_sel_hi:[1,0,0]
    v_pk_fma_f32 v[126:127], v[126:127], v[8:9], v[10:11] op_sel:[0,0,0] op_sel_hi:[1,0,0]
    v_pk_fma_f32 v[128:129], v[128:129], v[8:9], v[10:11] op_sel:[0,0,0] op_sel_hi:[1,0,0]
    v_pk_fma_f32 v[130:131], v[130:131], v[8:9], v[10:11] op_sel:[0,0,0] op_sel_hi:[1,0,0]
    v_cvt_pk_bf16_f32 v124, v124, v125
    v_cvt_pk_bf16_f32 v125, v126, v127
    v_cvt_pk_bf16_f32 v126, v128, v129
    v_cvt_pk_bf16_f32 v127, v130, v131
    buffer_store_dwordx4 v[124:127], v0, s[8:11], s24 offen offset:2048 nt
    v_pk_fma_f32 v[132:133], v[132:133], v[8:9], v[10:11] op_sel:[0,1,1] op_sel_hi:[1,1,1]
    v_pk_fma_f32 v[134:135], v[134:135], v[8:9], v[10:11] op_sel:[0,1,1] op_sel_hi:[1,1,1]
    v_pk_fma_f32 v[136:137], v[136:137], v[8:9], v[10:11] op_sel:[0,1,1] op_sel_hi:[1,1,1]
    v_pk_fma_f32 v[138:139], v[138:139], v[8:9], v[10:11] op_sel:[0,1,1] op_sel_hi:[1,1,1]
    v_cvt_pk_bf16_f32 v132, v132, v133
    v_cvt_pk_bf16_f32 v133, v134, v135
    v_cvt_pk_bf16_f32 v134, v136, v137
    v_cvt_pk_bf16_f32 v135, v138, v139
    buffer_store_dwordx4 v[132:135], v0, s[8:11], s24 offen offset:3072 nt
    v_pk_mul_f32 v[8:9], v[2:3], s[66:67] op_sel:[1,0] op_sel_hi:[1,1]
    v_pk_fma_f32 v[10:11], v[8:9], v[2:3], s[84:85] op_sel:[0,0,0] op_sel_hi:[1,0,1] neg_lo:[0,1,0] neg_hi:[0,1,0]
    v_pk_fma_f32 v[140:141], v[140:141], v[8:9], v[10:11] op_sel:[0,0,0] op_sel_hi:[1,0,0]
    v_pk_fma_f32 v[142:143], v[142:143], v[8:9], v[10:11] op_sel:[0,0,0] op_sel_hi:[1,0,0]
    v_pk_fma_f32 v[144:145], v[144:145], v[8:9], v[10:11] op_sel:[0,0,0] op_sel_hi:[1,0,0]
    v_pk_fma_f32 v[146:147], v[146:147], v[8:9], v[10:11] op_sel:[0,0,0] op_sel_hi:[1,0,0]
    v_cvt_pk_bf16_f32 v140, v140, v141
    v_cvt_pk_bf16_f32 v141, v142, v143
    v_cvt_pk_bf16_f32 v142, v144, v145
    v_cvt_pk_bf16_f32 v143, v146, v147
    buffer_store_dwordx4 v[140:143], v0, s[8:11], s25 offen nt
    v_pk_fma_f32 v[148:149], v[148:149], v[8:9], v[10:11] op_sel:[0,1,1] op_sel_hi:[1,1,1]
    v_pk_fma_f32 v[150:151], v[150:151], v[8:9], v[10:11] op_sel:[0,1,1] op_sel_hi:[1,1,1]
    v_pk_fma_f32 v[152:153], v[152:153], v[8:9], v[10:11] op_sel:[0,1,1] op_sel_hi:[1,1,1]
    v_pk_fma_f32 v[154:155], v[154:155], v[8:9], v[10:11] op_sel:[0,1,1] op_sel_hi:[1,1,1]
    v_cvt_pk_bf16_f32 v148, v148, v149
    v_cvt_pk_bf16_f32 v149, v150, v151
    v_cvt_pk_bf16_f32 v150, v152, v153
    v_cvt_pk_bf16_f32 v151, v154, v155
    buffer_store_dwordx4 v[148:151], v0, s[8:11], s25 offen offset:1024 nt
L_end:
    s_endpgm
.section .rodata,"a"
.p2align 6
.amdhsa_kernel standalone__groupnorm__sampling_kernel
  .amdhsa_next_free_vgpr 156
  .amdhsa_next_free_sgpr 86
  .amdhsa_accum_offset 156
  .amdhsa_group_segment_fixed_size 0
  .amdhsa_kernarg_size 48
  .amdhsa_user_sgpr_count 2
  .amdhsa_user_sgpr_kernarg_segment_ptr 1
  .amdhsa_system_sgpr_workgroup_id_x 1
  .amdhsa_float_denorm_mode_32 3
.end_amdhsa_kernel
```
